```python
import torch

def _softmax(x, axis=-1):
    return torch.softmax(x, dim=axis)
def _gelu(x):
    return torch.nn.functional.gelu(x, approximate="tanh")
def _silu(x):
    return torch.nn.functional.silu(x)
def _sigmoid(x):
    return torch.sigmoid(x)
def _layernorm(x, axis=-1, eps=1e-5):
    m = x.mean(dim=axis, keepdim=True)
    v = x.var(dim=axis, keepdim=True, unbiased=False)
    return (x - m) / torch.sqrt(v + eps)
def _scatter_add(tgt, idx, src, axis=0):
    return tgt.clone().index_add_(axis, idx, src)
def _segment_sum(src, seg, n):
    out = torch.zeros((n,) + src.shape[1:], dtype=src.dtype)
    return out.index_add_(0, seg, src)
def _pad(x, pw):
    flat = tuple(v for pair in reversed(pw) for v in pair)
    return torch.nn.functional.pad(x, flat)

kernel_name = 'standalone__consistency_rf_step__diffusion'

def setup_inputs():

    _w = (lambda a: (lambda t: t.to(torch.bfloat16) if t.is_floating_point() else t)(torch.as_tensor(a)))
    B, C, HW = 2, 128, 128
    return {
        "x": _w((lambda *s: torch.randn(*s, dtype=torch.bfloat16) * 0.05)(B, C, HW, HW)),
        "v": _w((lambda *s: torch.randn(*s, dtype=torch.bfloat16) * 0.05)(B, C, HW, HW)),
        "sigma": _w(torch.rand(B).to(float)),
    }

def reference(x, v, sigma):
    s = sigma.reshape(-1, 1, 1, 1)
    return x - s * v
```

```asm
; @launch grid=(256,1,1) block=(256,1,1) lds=0
.amdgcn_target "amdgcn-amd-amdhsa--gfx950"
.text
.p2align 12
.globl standalone__consistency_rf_step__diffusion_kernel
.p2align 8
.type standalone__consistency_rf_step__diffusion_kernel,@function
standalone__consistency_rf_step__diffusion_kernel:
    s_load_dwordx8 s[4:11], s[0:1], 0
    s_cmpk_ge_u32 s2, 256
    s_cbranch_scc1 L_end
    s_and_b32 s3, s2, 3
    s_lshl_b32 s3, s3, 15
    s_and_b32 s15, s2, 4
    s_lshl_b32 s15, s15, 20
    s_or_b32 s3, s3, s15
    s_lshr_b32 s15, s2, 3
    s_lshl_b32 s15, s15, 17
    s_or_b32 s3, s3, s15
    s_addk_i32 s3, 4096
    v_lshl_add_u32 v1, v0, 4, s3
    v_add_u32 v2, 8192, v1
    v_add_u32 v3, 16384, v1
    v_add_u32 v4, 24576, v1
    s_waitcnt lgkmcnt(0)
    global_load_dwordx4 v[24:27], v1, s[6:7] offset:-4096
    s_barrier
    global_load_dwordx4 v[20:23], v1, s[4:5] offset:-4096
    s_barrier
    global_load_dwordx4 v[32:35], v1, s[6:7]
    s_barrier
    global_load_dwordx4 v[28:31], v1, s[4:5]
    s_barrier
    global_load_dwordx4 v[40:43], v2, s[6:7] offset:-4096
    s_barrier
    global_load_dwordx4 v[36:39], v2, s[4:5] offset:-4096
    s_barrier
    global_load_dwordx4 v[48:51], v2, s[6:7]
    s_load_dword s12, s[8:9], 0
    s_mov_b32 s14, 0xffff0000
    s_bitcmp1_b32 s2, 2
    s_cselect_b32 s15, 0, 16
    s_waitcnt lgkmcnt(0)
    s_lshl_b32 s12, s12, s15
    s_and_b32 s12, s12, s14
    s_mov_b32 s13, s12
    s_waitcnt vmcnt(6)
    global_load_dwordx4 v[44:47], v2, s[4:5]
    v_lshlrev_b32 v6, 16, v24
    v_and_b32 v7, s14, v24
    v_pk_mul_f32 v[6:7], v[6:7], s[12:13]
    v_cvt_pk_bf16_f32 v24, v6, v7
    v_lshlrev_b32 v8, 16, v25
    v_and_b32 v9, s14, v25
    v_pk_mul_f32 v[8:9], v[8:9], s[12:13]
    v_cvt_pk_bf16_f32 v25, v8, v9
    v_lshlrev_b32 v6, 16, v26
    v_and_b32 v7, s14, v26
    v_pk_mul_f32 v[6:7], v[6:7], s[12:13]
    v_cvt_pk_bf16_f32 v26, v6, v7
    v_lshlrev_b32 v8, 16, v27
    v_and_b32 v9, s14, v27
    v_pk_mul_f32 v[8:9], v[8:9], s[12:13]
    v_cvt_pk_bf16_f32 v27, v8, v9
    v_lshlrev_b32 v10, 16, v24
    v_and_b32 v11, s14, v24
    v_lshlrev_b32 v12, 16, v25
    v_and_b32 v13, s14, v25
    v_lshlrev_b32 v14, 16, v26
    v_and_b32 v15, s14, v26
    v_lshlrev_b32 v16, 16, v27
    v_and_b32 v17, s14, v27
    s_waitcnt vmcnt(6)
    global_load_dwordx4 v[56:59], v3, s[6:7] offset:-4096
    v_lshlrev_b32 v6, 16, v20
    v_and_b32 v7, s14, v20
    v_pk_add_f32 v[6:7], v[6:7], v[10:11] neg_lo:[0,1] neg_hi:[0,1]
    v_cvt_pk_bf16_f32 v20, v6, v7
    v_lshlrev_b32 v8, 16, v21
    v_and_b32 v9, s14, v21
    v_pk_add_f32 v[8:9], v[8:9], v[12:13] neg_lo:[0,1] neg_hi:[0,1]
    v_cvt_pk_bf16_f32 v21, v8, v9
    v_lshlrev_b32 v6, 16, v22
    v_and_b32 v7, s14, v22
    v_pk_add_f32 v[6:7], v[6:7], v[14:15] neg_lo:[0,1] neg_hi:[0,1]
    v_cvt_pk_bf16_f32 v22, v6, v7
    v_lshlrev_b32 v8, 16, v23
    v_and_b32 v9, s14, v23
    v_pk_add_f32 v[8:9], v[8:9], v[16:17] neg_lo:[0,1] neg_hi:[0,1]
    v_cvt_pk_bf16_f32 v23, v8, v9
    global_store_dwordx4 v1, v[20:23], s[10:11] offset:-4096
    s_waitcnt vmcnt(7)
    global_load_dwordx4 v[52:55], v3, s[4:5] offset:-4096
    v_lshlrev_b32 v6, 16, v32
    v_and_b32 v7, s14, v32
    v_pk_mul_f32 v[6:7], v[6:7], s[12:13]
    v_cvt_pk_bf16_f32 v32, v6, v7
    v_lshlrev_b32 v8, 16, v33
    v_and_b32 v9, s14, v33
    v_pk_mul_f32 v[8:9], v[8:9], s[12:13]
    v_cvt_pk_bf16_f32 v33, v8, v9
    v_lshlrev_b32 v6, 16, v34
    v_and_b32 v7, s14, v34
    v_pk_mul_f32 v[6:7], v[6:7], s[12:13]
    v_cvt_pk_bf16_f32 v34, v6, v7
    v_lshlrev_b32 v8, 16, v35
    v_and_b32 v9, s14, v35
    v_pk_mul_f32 v[8:9], v[8:9], s[12:13]
    v_cvt_pk_bf16_f32 v35, v8, v9
    v_lshlrev_b32 v10, 16, v32
    v_and_b32 v11, s14, v32
    v_lshlrev_b32 v12, 16, v33
    v_and_b32 v13, s14, v33
    v_lshlrev_b32 v14, 16, v34
    v_and_b32 v15, s14, v34
    v_lshlrev_b32 v16, 16, v35
    v_and_b32 v17, s14, v35
    s_waitcnt vmcnt(7)
    global_load_dwordx4 v[64:67], v3, s[6:7]
    v_lshlrev_b32 v6, 16, v28
    v_and_b32 v7, s14, v28
    v_pk_add_f32 v[6:7], v[6:7], v[10:11] neg_lo:[0,1] neg_hi:[0,1]
    v_cvt_pk_bf16_f32 v28, v6, v7
    v_lshlrev_b32 v8, 16, v29
    v_and_b32 v9, s14, v29
    v_pk_add_f32 v[8:9], v[8:9], v[12:13] neg_lo:[0,1] neg_hi:[0,1]
    v_cvt_pk_bf16_f32 v29, v8, v9
    v_lshlrev_b32 v6, 16, v30
    v_and_b32 v7, s14, v30
    v_pk_add_f32 v[6:7], v[6:7], v[14:15] neg_lo:[0,1] neg_hi:[0,1]
    v_cvt_pk_bf16_f32 v30, v6, v7
    v_lshlrev_b32 v8, 16, v31
    v_and_b32 v9, s14, v31
    v_pk_add_f32 v[8:9], v[8:9], v[16:17] neg_lo:[0,1] neg_hi:[0,1]
    v_cvt_pk_bf16_f32 v31, v8, v9
    global_store_dwordx4 v1, v[28:31], s[10:11]
    s_waitcnt vmcnt(8)
    global_load_dwordx4 v[60:63], v3, s[4:5]
    v_lshlrev_b32 v6, 16, v40
    v_and_b32 v7, s14, v40
    v_pk_mul_f32 v[6:7], v[6:7], s[12:13]
    v_cvt_pk_bf16_f32 v40, v6, v7
    v_lshlrev_b32 v8, 16, v41
    v_and_b32 v9, s14, v41
    v_pk_mul_f32 v[8:9], v[8:9], s[12:13]
    v_cvt_pk_bf16_f32 v41, v8, v9
    v_lshlrev_b32 v6, 16, v42
    v_and_b32 v7, s14, v42
    v_pk_mul_f32 v[6:7], v[6:7], s[12:13]
    v_cvt_pk_bf16_f32 v42, v6, v7
    v_lshlrev_b32 v8, 16, v43
    v_and_b32 v9, s14, v43
    v_pk_mul_f32 v[8:9], v[8:9], s[12:13]
    v_cvt_pk_bf16_f32 v43, v8, v9
    v_lshlrev_b32 v10, 16, v40
    v_and_b32 v11, s14, v40
    v_lshlrev_b32 v12, 16, v41
    v_and_b32 v13, s14, v41
    v_lshlrev_b32 v14, 16, v42
    v_and_b32 v15, s14, v42
    v_lshlrev_b32 v16, 16, v43
    v_and_b32 v17, s14, v43
    s_waitcnt vmcnt(8)
    global_load_dwordx4 v[72:75], v4, s[6:7] offset:-4096
    v_lshlrev_b32 v6, 16, v36
    v_and_b32 v7, s14, v36
    v_pk_add_f32 v[6:7], v[6:7], v[10:11] neg_lo:[0,1] neg_hi:[0,1]
    v_cvt_pk_bf16_f32 v36, v6, v7
    v_lshlrev_b32 v8, 16, v37
    v_and_b32 v9, s14, v37
    v_pk_add_f32 v[8:9], v[8:9], v[12:13] neg_lo:[0,1] neg_hi:[0,1]
    v_cvt_pk_bf16_f32 v37, v8, v9
    v_lshlrev_b32 v6, 16, v38
    v_and_b32 v7, s14, v38
    v_pk_add_f32 v[6:7], v[6:7], v[14:15] neg_lo:[0,1] neg_hi:[0,1]
    v_cvt_pk_bf16_f32 v38, v6, v7
    v_lshlrev_b32 v8, 16, v39
    v_and_b32 v9, s14, v39
    v_pk_add_f32 v[8:9], v[8:9], v[16:17] neg_lo:[0,1] neg_hi:[0,1]
    v_cvt_pk_bf16_f32 v39, v8, v9
    global_store_dwordx4 v2, v[36:39], s[10:11] offset:-4096
    s_waitcnt vmcnt(9)
    global_load_dwordx4 v[68:71], v4, s[4:5] offset:-4096
    v_lshlrev_b32 v6, 16, v48
    v_and_b32 v7, s14, v48
    v_pk_mul_f32 v[6:7], v[6:7], s[12:13]
    v_cvt_pk_bf16_f32 v48, v6, v7
    v_lshlrev_b32 v8, 16, v49
    v_and_b32 v9, s14, v49
    v_pk_mul_f32 v[8:9], v[8:9], s[12:13]
    v_cvt_pk_bf16_f32 v49, v8, v9
    v_lshlrev_b32 v6, 16, v50
    v_and_b32 v7, s14, v50
    v_pk_mul_f32 v[6:7], v[6:7], s[12:13]
    v_cvt_pk_bf16_f32 v50, v6, v7
    v_lshlrev_b32 v8, 16, v51
    v_and_b32 v9, s14, v51
    v_pk_mul_f32 v[8:9], v[8:9], s[12:13]
    v_cvt_pk_bf16_f32 v51, v8, v9
    v_lshlrev_b32 v10, 16, v48
    v_and_b32 v11, s14, v48
    v_lshlrev_b32 v12, 16, v49
    v_and_b32 v13, s14, v49
    v_lshlrev_b32 v14, 16, v50
    v_and_b32 v15, s14, v50
    v_lshlrev_b32 v16, 16, v51
    v_and_b32 v17, s14, v51
    s_waitcnt vmcnt(9)
    global_load_dwordx4 v[80:83], v4, s[6:7]
    v_lshlrev_b32 v6, 16, v44
    v_and_b32 v7, s14, v44
    v_pk_add_f32 v[6:7], v[6:7], v[10:11] neg_lo:[0,1] neg_hi:[0,1]
    v_cvt_pk_bf16_f32 v44, v6, v7
    v_lshlrev_b32 v8, 16, v45
    v_and_b32 v9, s14, v45
    v_pk_add_f32 v[8:9], v[8:9], v[12:13] neg_lo:[0,1] neg_hi:[0,1]
    v_cvt_pk_bf16_f32 v45, v8, v9
    v_lshlrev_b32 v6, 16, v46
    v_and_b32 v7, s14, v46
    v_pk_add_f32 v[6:7], v[6:7], v[14:15] neg_lo:[0,1] neg_hi:[0,1]
    v_cvt_pk_bf16_f32 v46, v6, v7
    v_lshlrev_b32 v8, 16, v47
    v_and_b32 v9, s14, v47
    v_pk_add_f32 v[8:9], v[8:9], v[16:17] neg_lo:[0,1] neg_hi:[0,1]
    v_cvt_pk_bf16_f32 v47, v8, v9
    global_store_dwordx4 v2, v[44:47], s[10:11]
    s_waitcnt vmcnt(10)
    global_load_dwordx4 v[76:79], v4, s[4:5]
    v_lshlrev_b32 v6, 16, v56
    v_and_b32 v7, s14, v56
    v_pk_mul_f32 v[6:7], v[6:7], s[12:13]
    v_cvt_pk_bf16_f32 v56, v6, v7
    v_lshlrev_b32 v8, 16, v57
    v_and_b32 v9, s14, v57
    v_pk_mul_f32 v[8:9], v[8:9], s[12:13]
    v_cvt_pk_bf16_f32 v57, v8, v9
    v_lshlrev_b32 v6, 16, v58
    v_and_b32 v7, s14, v58
    v_pk_mul_f32 v[6:7], v[6:7], s[12:13]
    v_cvt_pk_bf16_f32 v58, v6, v7
    v_lshlrev_b32 v8, 16, v59
    v_and_b32 v9, s14, v59
    v_pk_mul_f32 v[8:9], v[8:9], s[12:13]
    v_cvt_pk_bf16_f32 v59, v8, v9
    v_lshlrev_b32 v10, 16, v56
    v_and_b32 v11, s14, v56
    v_lshlrev_b32 v12, 16, v57
    v_and_b32 v13, s14, v57
    v_lshlrev_b32 v14, 16, v58
    v_and_b32 v15, s14, v58
    v_lshlrev_b32 v16, 16, v59
    v_and_b32 v17, s14, v59
    s_waitcnt vmcnt(9)
    v_lshlrev_b32 v6, 16, v52
    v_and_b32 v7, s14, v52
    v_pk_add_f32 v[6:7], v[6:7], v[10:11] neg_lo:[0,1] neg_hi:[0,1]
    v_cvt_pk_bf16_f32 v52, v6, v7
    v_lshlrev_b32 v8, 16, v53
    v_and_b32 v9, s14, v53
    v_pk_add_f32 v[8:9], v[8:9], v[12:13] neg_lo:[0,1] neg_hi:[0,1]
    v_cvt_pk_bf16_f32 v53, v8, v9
    v_lshlrev_b32 v6, 16, v54
    v_and_b32 v7, s14, v54
    v_pk_add_f32 v[6:7], v[6:7], v[14:15] neg_lo:[0,1] neg_hi:[0,1]
    v_cvt_pk_bf16_f32 v54, v6, v7
    v_lshlrev_b32 v8, 16, v55
    v_and_b32 v9, s14, v55
    v_pk_add_f32 v[8:9], v[8:9], v[16:17] neg_lo:[0,1] neg_hi:[0,1]
    v_cvt_pk_bf16_f32 v55, v8, v9
    global_store_dwordx4 v3, v[52:55], s[10:11] offset:-4096
    s_waitcnt vmcnt(9)
    v_lshlrev_b32 v6, 16, v64
    v_and_b32 v7, s14, v64
    v_pk_mul_f32 v[6:7], v[6:7], s[12:13]
    v_cvt_pk_bf16_f32 v64, v6, v7
    v_lshlrev_b32 v8, 16, v65
    v_and_b32 v9, s14, v65
    v_pk_mul_f32 v[8:9], v[8:9], s[12:13]
    v_cvt_pk_bf16_f32 v65, v8, v9
    v_lshlrev_b32 v6, 16, v66
    v_and_b32 v7, s14, v66
    v_pk_mul_f32 v[6:7], v[6:7], s[12:13]
    v_cvt_pk_bf16_f32 v66, v6, v7
    v_lshlrev_b32 v8, 16, v67
    v_and_b32 v9, s14, v67
    v_pk_mul_f32 v[8:9], v[8:9], s[12:13]
    v_cvt_pk_bf16_f32 v67, v8, v9
    v_lshlrev_b32 v10, 16, v64
    v_and_b32 v11, s14, v64
    v_lshlrev_b32 v12, 16, v65
    v_and_b32 v13, s14, v65
    v_lshlrev_b32 v14, 16, v66
    v_and_b32 v15, s14, v66
    v_lshlrev_b32 v16, 16, v67
    v_and_b32 v17, s14, v67
    s_waitcnt vmcnt(7)
    v_lshlrev_b32 v6, 16, v60
    v_and_b32 v7, s14, v60
    v_pk_add_f32 v[6:7], v[6:7], v[10:11] neg_lo:[0,1] neg_hi:[0,1]
    v_cvt_pk_bf16_f32 v60, v6, v7
    v_lshlrev_b32 v8, 16, v61
    v_and_b32 v9, s14, v61
    v_pk_add_f32 v[8:9], v[8:9], v[12:13] neg_lo:[0,1] neg_hi:[0,1]
    v_cvt_pk_bf16_f32 v61, v8, v9
    v_lshlrev_b32 v6, 16, v62
    v_and_b32 v7, s14, v62
    v_pk_add_f32 v[6:7], v[6:7], v[14:15] neg_lo:[0,1] neg_hi:[0,1]
    v_cvt_pk_bf16_f32 v62, v6, v7
    v_lshlrev_b32 v8, 16, v63
    v_and_b32 v9, s14, v63
    v_pk_add_f32 v[8:9], v[8:9], v[16:17] neg_lo:[0,1] neg_hi:[0,1]
    v_cvt_pk_bf16_f32 v63, v8, v9
    global_store_dwordx4 v3, v[60:63], s[10:11]
    s_waitcnt vmcnt(7)
    v_lshlrev_b32 v6, 16, v72
    v_and_b32 v7, s14, v72
    v_pk_mul_f32 v[6:7], v[6:7], s[12:13]
    v_cvt_pk_bf16_f32 v72, v6, v7
    v_lshlrev_b32 v8, 16, v73
    v_and_b32 v9, s14, v73
    v_pk_mul_f32 v[8:9], v[8:9], s[12:13]
    v_cvt_pk_bf16_f32 v73, v8, v9
    v_lshlrev_b32 v6, 16, v74
    v_and_b32 v7, s14, v74
    v_pk_mul_f32 v[6:7], v[6:7], s[12:13]
    v_cvt_pk_bf16_f32 v74, v6, v7
    v_lshlrev_b32 v8, 16, v75
    v_and_b32 v9, s14, v75
    v_pk_mul_f32 v[8:9], v[8:9], s[12:13]
    v_cvt_pk_bf16_f32 v75, v8, v9
    v_lshlrev_b32 v10, 16, v72
    v_and_b32 v11, s14, v72
    v_lshlrev_b32 v12, 16, v73
    v_and_b32 v13, s14, v73
    v_lshlrev_b32 v14, 16, v74
    v_and_b32 v15, s14, v74
    v_lshlrev_b32 v16, 16, v75
    v_and_b32 v17, s14, v75
    s_waitcnt vmcnt(5)
    v_lshlrev_b32 v6, 16, v68
    v_and_b32 v7, s14, v68
    v_pk_add_f32 v[6:7], v[6:7], v[10:11] neg_lo:[0,1] neg_hi:[0,1]
    v_cvt_pk_bf16_f32 v68, v6, v7
    v_lshlrev_b32 v8, 16, v69
    v_and_b32 v9, s14, v69
    v_pk_add_f32 v[8:9], v[8:9], v[12:13] neg_lo:[0,1] neg_hi:[0,1]
    v_cvt_pk_bf16_f32 v69, v8, v9
    v_lshlrev_b32 v6, 16, v70
    v_and_b32 v7, s14, v70
    v_pk_add_f32 v[6:7], v[6:7], v[14:15] neg_lo:[0,1] neg_hi:[0,1]
    v_cvt_pk_bf16_f32 v70, v6, v7
    v_lshlrev_b32 v8, 16, v71
    v_and_b32 v9, s14, v71
    v_pk_add_f32 v[8:9], v[8:9], v[16:17] neg_lo:[0,1] neg_hi:[0,1]
    v_cvt_pk_bf16_f32 v71, v8, v9
    global_store_dwordx4 v4, v[68:71], s[10:11] offset:-4096
    s_waitcnt vmcnt(5)
    v_lshlrev_b32 v6, 16, v80
    v_and_b32 v7, s14, v80
    v_pk_mul_f32 v[6:7], v[6:7], s[12:13]
    v_cvt_pk_bf16_f32 v80, v6, v7
    v_lshlrev_b32 v8, 16, v81
    v_and_b32 v9, s14, v81
    v_pk_mul_f32 v[8:9], v[8:9], s[12:13]
    v_cvt_pk_bf16_f32 v81, v8, v9
    v_lshlrev_b32 v6, 16, v82
    v_and_b32 v7, s14, v82
    v_pk_mul_f32 v[6:7], v[6:7], s[12:13]
    v_cvt_pk_bf16_f32 v82, v6, v7
    v_lshlrev_b32 v8, 16, v83
    v_and_b32 v9, s14, v83
    v_pk_mul_f32 v[8:9], v[8:9], s[12:13]
    v_cvt_pk_bf16_f32 v83, v8, v9
    v_lshlrev_b32 v10, 16, v80
    v_and_b32 v11, s14, v80
    v_lshlrev_b32 v12, 16, v81
    v_and_b32 v13, s14, v81
    v_lshlrev_b32 v14, 16, v82
    v_and_b32 v15, s14, v82
    v_lshlrev_b32 v16, 16, v83
    v_and_b32 v17, s14, v83
    s_waitcnt vmcnt(3)
    v_lshlrev_b32 v6, 16, v76
    v_and_b32 v7, s14, v76
    v_pk_add_f32 v[6:7], v[6:7], v[10:11] neg_lo:[0,1] neg_hi:[0,1]
    v_cvt_pk_bf16_f32 v76, v6, v7
    v_lshlrev_b32 v8, 16, v77
    v_and_b32 v9, s14, v77
    v_pk_add_f32 v[8:9], v[8:9], v[12:13] neg_lo:[0,1] neg_hi:[0,1]
    v_cvt_pk_bf16_f32 v77, v8, v9
    v_lshlrev_b32 v6, 16, v78
    v_and_b32 v7, s14, v78
    v_pk_add_f32 v[6:7], v[6:7], v[14:15] neg_lo:[0,1] neg_hi:[0,1]
    v_cvt_pk_bf16_f32 v78, v6, v7
    v_lshlrev_b32 v8, 16, v79
    v_and_b32 v9, s14, v79
    v_pk_add_f32 v[8:9], v[8:9], v[16:17] neg_lo:[0,1] neg_hi:[0,1]
    v_cvt_pk_bf16_f32 v79, v8, v9
    global_store_dwordx4 v4, v[76:79], s[10:11]
L_end:
    s_endpgm
.section .rodata,"a"
.p2align 6
.amdhsa_kernel standalone__consistency_rf_step__diffusion_kernel
  .amdhsa_next_free_vgpr 84
  .amdhsa_next_free_sgpr 16
  .amdhsa_accum_offset 84
  .amdhsa_group_segment_fixed_size 0
  .amdhsa_kernarg_size 48
  .amdhsa_user_sgpr_count 2
  .amdhsa_user_sgpr_kernarg_segment_ptr 1
  .amdhsa_system_sgpr_workgroup_id_x 1
  .amdhsa_float_denorm_mode_32 3
.end_amdhsa_kernel
```
